```python
import torch

def _softmax(x, axis=-1):
    return torch.softmax(x, dim=axis)
def _gelu(x):
    return torch.nn.functional.gelu(x, approximate="tanh")
def _silu(x):
    return torch.nn.functional.silu(x)
def _sigmoid(x):
    return torch.sigmoid(x)
def _layernorm(x, axis=-1, eps=1e-5):
    m = x.mean(dim=axis, keepdim=True)
    v = x.var(dim=axis, keepdim=True, unbiased=False)
    return (x - m) / torch.sqrt(v + eps)
def _scatter_add(tgt, idx, src, axis=0):
    return tgt.clone().index_add_(axis, idx, src)
def _segment_sum(src, seg, n):
    out = torch.zeros((n,) + src.shape[1:], dtype=src.dtype)
    return out.index_add_(0, seg, src)
def _pad(x, pw):
    flat = tuple(v for pair in reversed(pw) for v in pair)
    return torch.nn.functional.pad(x, flat)

kernel_name = 'standalone__groupnorm__prompt'

def setup_inputs():

    _w = (lambda a: (lambda t: t.to(torch.bfloat16) if t.is_floating_point() else t)(torch.as_tensor(a)))
    B = 1
    G = 32
    cpg = max(1, 448 // G)
    C = G * cpg
    H, W = 16, 2048
    return {
        "x": _w(abs((lambda *s: torch.randn(*s, dtype=torch.bfloat16) * 0.05)(B, C, H, W))),
        "g": _w((lambda *s: torch.randn(*s, dtype=torch.bfloat16) * 0.05)(C) + 1.0),
        "b": _w((lambda *s: torch.randn(*s, dtype=torch.bfloat16) * 0.4)(C)),
    }

def reference(x, g, b):
    G = 32
    B, C, H, W = x.shape[0], x.shape[1], x.shape[2], x.shape[3]
    xr = x.reshape(B, G, C // G, H, W)
    mu = xr.mean(axis=(2, 3, 4), keepdims=True)
    var = ((xr - mu) ** 2).mean(axis=(2, 3, 4), keepdims=True)
    xn = (xr - mu) / torch.sqrt(var + 1e-5)
    xn = xn.reshape(B, C, H, W)
    return xn * g[None, :, None, None] + b[None, :, None, None]
```

```asm
; @launch grid=(256,1,1) block=(512,1,1) lds=128
.amdgcn_target "amdgcn-amd-amdhsa--gfx950"
.text
.globl standalone__groupnorm__prompt_kernel
.p2align 12
.fill 832, 4, 0xbf800000
.p2align 8
.type standalone__groupnorm__prompt_kernel,@function
standalone__groupnorm__prompt_kernel:
  s_load_dwordx2 s[16:17], s[0:1], 0
  s_load_dwordx4 s[4:7], s[0:1], 8
  s_load_dwordx2 s[20:21], s[0:1], 24
  s_load_dwordx4 s[8:11], s[0:1], 32
  v_lshrrev_b32 v2, 6, v0
  s_cmp_ge_u32 s2, 256
  s_cbranch_scc1 L_end
  v_readfirstlane_b32 s27, v2
  v_and_b32 v3, 63, v0
  s_mov_b32 s3, s2
  s_cmp_lt_u32 s27, 4
  s_cselect_b32 s54, 3, 2
  s_cselect_b32 s12, 0, 1
  s_lshr_b32 s13, s3, s54
  s_bfm_b32 s15, s54, 0
  s_and_b32 s15, s3, s15
  s_lshl1_add_u32 s12, s15, s12
  s_lshr_b32 s15, s13, 4
  s_lshl_b32 s15, s15, s54
  s_lshl1_add_u32 s12, s15, s12
  s_and_b32 s13, s13, 15
  s_mul_i32 s14, s12, 917504
  s_lshr_b32 s15, s13, 2
  s_lshl_b32 s15, s15, 14
  s_and_b32 s53, s13, 2
  s_and_b32 s55, s27, 3
  s_lshl1_add_u32 s53, s53, s55
  s_lshl_b32 s53, s53, 10
  s_add_u32 s14, s14, s15
  s_add_u32 s14, s14, s53
  v_lshlrev_b32 v1, 4, v3
  s_mov_b32 s18, 29360128
  s_mov_b32 s19, 0x20000
  s_bfe_i32 s52, s13, 0x10000
  s_xor_b32 s52, s52, 0x2aaa
  v_lshl_add_u32 v5, v3, 16, s14
  s_sub_u32 s15, s2, 64
  s_lshl_b32 s47, s27, 8
  s_add_u32 s15, s15, s47
  s_lshl_b32 s47, s15, 10
  v_add_u32 v6, s47, v1
  v_add_u32 v7, 0x2000, v6
  v_mov_b32 v64, -1
  v_mov_b32 v65, -1
  v_mov_b32 v66, -1
  v_mov_b32 v67, -1
  s_lshl_b32 s47, 1, s15
  s_cmp_lt_u32 s15, 8
  s_cselect_b32 s47, s47, 0
  s_cmp_lt_u32 s27, 6
  s_cbranch_scc1 L_rows
  v_mov_b32 v4, 0
  v_and_b32 v6, 0x7c, v1
  ds_write_b32 v6, v4 offset:0
  s_and_b32 s56, s2, 7
  s_cmp_lt_u32 s56, 5
  s_cselect_b32 s15, s2, 56
  s_cmp_eq_u32 s27, 6
  s_cselect_b32 s15, s15, 56
  s_cmp_lt_u32 s15, 56
  s_cbranch_scc1 L_probe
  s_getreg_b32 s60, hwreg(HW_REG_XCC_ID, 0, 3)
  s_sub_u32 s60, s60, s2
  s_and_b32 s60, s60, 7
  s_or_b32 s60, s60, 8
  s_mov_b32 s61, 0
  s_lshr_b32 s15, s2, 3
  s_lshl3_add_u32 s15, s15, s27
  s_cmp_lg_u32 s15, 62
  s_waitcnt lgkmcnt(0)
  s_cbranch_scc1 L_late
  s_atomic_cmpswap s[60:61], s[8:9], 16
L_late:
  s_mov_b64 exec, 0
  s_bitcmp1_b32 s27, 0
  s_cbranch_scc1 L_ch7
  s_branch L_ch0
L_probe:
  s_and_b32 s15, s2, 1
  s_lshr_b32 s54, s2, 3
  s_lshl1_add_u32 s55, s54, s15
  s_lshl_b32 s57, s55, 21
  s_mul_i32 s58, s56, 155904
  s_add_u32 s57, s57, s58
  s_xor_b32 s58, s57, 0x2000
  s_getreg_b32 s59, hwreg(HW_REG_XCC_ID, 0, 3)
  s_waitcnt lgkmcnt(0)
  s_add_u32 s64, s20, s57
  s_addc_u32 s65, s21, 0
  s_add_u32 s66, s20, s58
  s_addc_u32 s67, s21, 0
  s_load_dword s72, s[64:65], 0
  s_load_dwordx2 s[62:63], s[66:67], 0
  s_lshr_b32 s57, s64, 13
  s_lshr_b32 s58, s59, 2
  s_xor_b32 s57, s57, s58
  s_xnor_b32 s57, s57, s55
  s_lshl3_add_u32 s56, s54, s56
  s_lshl_b32 s56, s56, 1
  s_lshr_b32 s54, s54, 1
  s_lshl_b32 s61, s54, 2
  s_waitcnt lgkmcnt(2)
  s_getreg_b32 s15, hwreg(HW_REG_IB_STS, 9, 1)
  s_xor_b32 s57, s57, s15
  s_and_b32 s57, s57, 1
  s_sub_u32 s57, 2, s57
  s_lshl_b32 s60, s57, s56
  s_atomic_or s60, s[8:9], s61
  s_branch L_late
L_rows:
  v_lshrrev_b32_e64 v4, v3, s52
  v_and_b32 v4, 1, v4
  v_lshl_add_u32 v4, v4, 13, v5
  s_mov_b32 s29, 0x3f803f80
  v_readlane_b32 s48, v4, 0
  v_readlane_b32 s49, v4, 1
  v_readlane_b32 s50, v4, 2
  v_readlane_b32 s51, v4, 3
  v_readlane_b32 s52, v4, 4
  v_readlane_b32 s53, v4, 5
  v_readlane_b32 s54, v4, 6
  v_readlane_b32 s55, v4, 7
  v_readlane_b32 s56, v4, 8
  v_readlane_b32 s57, v4, 9
  v_readlane_b32 s58, v4, 10
  v_readlane_b32 s59, v4, 11
  v_readlane_b32 s60, v4, 12
  v_readlane_b32 s61, v4, 13
  s_cmp_lg_u32 s47, 0
  s_waitcnt lgkmcnt(0)
  s_cbranch_scc0 L_ncl
  global_store_dwordx4 v6, v[64:67], s[10:11] sc1
  global_store_dwordx4 v7, v[64:67], s[10:11] sc1
L_ncl:
  s_cmp_lt_u32 s27, 6
  buffer_load_dwordx4 v[8:11], v1, s[16:19], s48 offen nt
  buffer_load_dwordx4 v[12:15], v1, s[16:19], s49 offen nt
  buffer_load_dwordx4 v[16:19], v1, s[16:19], s50 offen nt
  buffer_load_dwordx4 v[20:23], v1, s[16:19], s51 offen nt
  buffer_load_dwordx4 v[24:27], v1, s[16:19], s52 offen nt
  buffer_load_dwordx4 v[28:31], v1, s[16:19], s53 offen nt
  buffer_load_dwordx4 v[32:35], v1, s[16:19], s54 offen nt
  buffer_load_dwordx4 v[36:39], v1, s[16:19], s55 offen nt
  s_cbranch_scc1 L_nb2
  s_barrier
L_nb2:
  buffer_load_dwordx4 v[40:43], v1, s[16:19], s56 offen nt
  buffer_load_dwordx4 v[44:47], v1, s[16:19], s57 offen nt
  buffer_load_dwordx4 v[48:51], v1, s[16:19], s58 offen nt
  buffer_load_dwordx4 v[52:55], v1, s[16:19], s59 offen nt
  buffer_load_dwordx4 v[56:59], v1, s[16:19], s60 offen nt
  buffer_load_dwordx4 v[60:63], v1, s[16:19], s61 offen nt
  s_cbranch_scc0 L_nogate
  s_cmp_eq_u32 s47, 0
  s_cbranch_scc1 L_ncl2
  s_waitcnt vmcnt(14)
  s_atomic_or s47, s[8:9], 128
L_ncl2:
  s_barrier
  s_cmp_lt_u32 s27, 4
  s_cbranch_scc1 L_nogate
  s_barrier
  s_branch L_nogate
L_dretry:
  v_mov_b32 v6, 0
  global_load_dwordx4 v[8:11], v6, s[8:9] sc1
  global_load_dword v12, v6, s[8:9] offset:16 sc1
  s_add_u32 s31, s31, 1
  s_bitcmp1_b32 s31, 20
  s_waitcnt vmcnt(0)
  s_cbranch_scc1 L_dok
  v_readfirstlane_b32 s48, v8
  v_readfirstlane_b32 s49, v9
  v_readfirstlane_b32 s50, v10
  v_readfirstlane_b32 s51, v11
  v_readfirstlane_b32 s60, v12
  s_branch L_chk
L_gretry:
  v_mov_b32 v6, 0
  global_load_dword v6, v6, s[8:9] offset:192 sc1
  s_add_u32 s31, s31, 1
  s_bitcmp1_b32 s31, 20
  s_waitcnt vmcnt(0)
  s_cbranch_scc1 L_g2
  v_readfirstlane_b32 s2, v6
  s_cmp_lt_u32 s2, 0xff
  s_cbranch_scc1 L_gretry
  s_branch L_g2
L_cretry:
  v_mov_b32 v6, 0
  global_load_dword v6, v6, s[8:9] offset:128 sc1
  s_add_u32 s31, s31, 1
  s_bitcmp1_b32 s31, 20
  s_cbranch_scc1 L_c2
  s_waitcnt vmcnt(0)
  v_readfirstlane_b32 s47, v6
  s_andn2_b32 s47, s15, s47
  s_cbranch_scc1 L_cretry
  s_branch L_c2
L_back:
  s_mov_b64 exec, -1
  s_mul_i32 s54, s12, 14
  s_lshr_b32 s55, s54, 5
  s_and_b32 s54, s54, 31
  s_sub_u32 s54, 32, s54
  s_bfm_b64 s[56:57], s54, 0
  s_add_u32 s54, s55, 1
  s_min_u32 s54, s54, 13
  s_andn2_b32 s58, s55, 1
  s_lshl_b32 s58, s58, 3
  s_andn2_b32 s59, s54, 1
  s_lshl_b32 s59, s59, 3
  s_mov_b32 s31, 0
  s_add_u32 s53, s53, s20
  s_lshr_b32 s53, s53, 13
  s_barrier
  s_load_dwordx4 s[48:51], s[8:9], 0
  s_load_dword s60, s[8:9], 16
  s_waitcnt lgkmcnt(0)
L_chk:
  s_bitcmp1_b32 s55, 3
  s_cselect_b64 s[28:29], s[50:51], s[48:49]
  s_lshr_b64 s[28:29], s[28:29], s58
  s_bitcmp1_b32 s54, 3
  s_cselect_b64 s[48:49], s[50:51], s[48:49]
  s_lshr_b64 s[48:49], s[48:49], s59
  s_and_b32 s15, s28, 0x5555
  s_bcnt1_i32_b32 s15, s15
  s_and_b32 s28, s28, 0xaaaa
  s_bcnt1_i32_b32 s28, s28
  s_and_b32 s57, s48, 0x5555
  s_bcnt1_i32_b32 s57, s57
  s_and_b32 s48, s48, 0xaaaa
  s_bcnt1_i32_b32 s48, s48
  s_max_u32 s28, s28, s15
  s_max_u32 s48, s48, s57
  s_min_u32 s28, s28, s48
  s_min_u32 s28, s28, s60
  s_cmp_le_u32 s28, 2
  s_cbranch_scc1 L_dretry
L_dok:
  s_add_u32 s51, s60, s2
  s_lshr_b32 s51, s51, 2
  s_xor_b32 s51, s51, s53
  s_cmp_gt_u32 s15, 2
  s_addc_u32 s15, s55, s51
  s_cmp_gt_u32 s57, 2
  s_addc_u32 s57, s54, s51
  s_bfe_i32 s15, s15, 0x10000
  s_bfe_i32 s57, s57, 0x10000
  s_and_b32 s15, s15, s56
  s_andn2_b32 s57, s57, s56
  s_or_b32 s52, s57, s15
  s_branch L_rows
L_nogate:
  s_mul_i32 s15, s12, 28
  s_add_u32 s4, s4, s15
  s_addc_u32 s5, s5, 0
  s_add_u32 s6, s6, s15
  s_addc_u32 s7, s7, 0
  s_load_dwordx4 s[32:35], s[4:5], 0
  s_load_dwordx2 s[36:37], s[4:5], 16
  s_load_dword s38, s[4:5], 24
  s_load_dwordx4 s[40:43], s[6:7], 0
  s_load_dwordx2 s[44:45], s[6:7], 16
  s_load_dword s46, s[6:7], 24
  s_and_b32 s15, s3, 7
  s_lshl_b32 s15, 1, s15
  s_lshr_b32 s3, s3, 3
  s_cmp_eq_u32 s3, 31
  s_cselect_b32 s3, s15, 0
  s_mov_b32 s22, 29360128
  s_mov_b32 s23, 0x20000
  s_mov_b32 s30, 0xffff0000
  v_mov_b32 v4, 0
  v_mov_b32 v5, 0
  v_mov_b32 v6, 0
  v_mov_b32 v7, 0
  s_xor_b32 s26, s12, 1
  s_lshl_b32 s26, s26, 9
  v_and_b32 v64, 3, v3
  v_lshlrev_b32 v65, 3, v64
  v_lshl_add_u32 v64, v64, 7, s26
  s_lshl_b32 s15, s13, 3
  v_add_u32 v64, s15, v64
  s_and_b32 s15, s27, 4
  s_lshl_b32 s15, s15, 4
  v_add_u32 v65, s15, v65
  s_and_b32 s14, s27, 3
  s_lshl3_add_u32 s14, s14, s15
  v_mov_b32 v2, s14
  v_mov_b32 v0, s15
  s_lshr_b32 s15, s13, 2
  s_and_b32 s15, s15, 3
  s_lshl_b32 s15, s15, 7
  s_add_u32 s28, s26, 0
  s_add_u32 s14, s26, 512
  s_cmp_lt_u32 s27, 4
  s_cselect_b32 s13, 15, 15
  s_cselect_b32 s15, 0, s15
  s_cselect_b32 s28, s28, s14
  s_add_u32 s26, s26, s15
  s_mov_b32 s31, 0
  s_waitcnt vmcnt(13)
  v_dot2c_f32_bf16 v4, s29, v8
  v_dot2c_f32_bf16 v5, v8, v8
  v_dot2c_f32_bf16 v6, s29, v9
  v_dot2c_f32_bf16 v7, v9, v9
  v_dot2c_f32_bf16 v4, s29, v10
  v_dot2c_f32_bf16 v5, v10, v10
  v_dot2c_f32_bf16 v6, s29, v11
  v_dot2c_f32_bf16 v7, v11, v11
  s_waitcnt vmcnt(12)
  v_dot2c_f32_bf16 v4, s29, v12
  v_dot2c_f32_bf16 v5, v12, v12
  v_dot2c_f32_bf16 v6, s29, v13
  v_dot2c_f32_bf16 v7, v13, v13
  v_dot2c_f32_bf16 v4, s29, v14
  v_dot2c_f32_bf16 v5, v14, v14
  v_dot2c_f32_bf16 v6, s29, v15
  v_dot2c_f32_bf16 v7, v15, v15
  s_waitcnt vmcnt(11)
  v_dot2c_f32_bf16 v4, s29, v16
  v_dot2c_f32_bf16 v5, v16, v16
  v_dot2c_f32_bf16 v6, s29, v17
  v_dot2c_f32_bf16 v7, v17, v17
  v_dot2c_f32_bf16 v4, s29, v18
  v_dot2c_f32_bf16 v5, v18, v18
  v_dot2c_f32_bf16 v6, s29, v19
  v_dot2c_f32_bf16 v7, v19, v19
  s_waitcnt vmcnt(10)
  v_dot2c_f32_bf16 v4, s29, v20
  v_dot2c_f32_bf16 v5, v20, v20
  v_dot2c_f32_bf16 v6, s29, v21
  v_dot2c_f32_bf16 v7, v21, v21
  v_dot2c_f32_bf16 v4, s29, v22
  v_dot2c_f32_bf16 v5, v22, v22
  v_dot2c_f32_bf16 v6, s29, v23
  v_dot2c_f32_bf16 v7, v23, v23
  s_waitcnt vmcnt(9)
  v_dot2c_f32_bf16 v4, s29, v24
  v_dot2c_f32_bf16 v5, v24, v24
  v_dot2c_f32_bf16 v6, s29, v25
  v_dot2c_f32_bf16 v7, v25, v25
  v_dot2c_f32_bf16 v4, s29, v26
  v_dot2c_f32_bf16 v5, v26, v26
  v_dot2c_f32_bf16 v6, s29, v27
  v_dot2c_f32_bf16 v7, v27, v27
  s_waitcnt vmcnt(8)
  v_dot2c_f32_bf16 v4, s29, v28
  v_dot2c_f32_bf16 v5, v28, v28
  v_dot2c_f32_bf16 v6, s29, v29
  v_dot2c_f32_bf16 v7, v29, v29
  v_dot2c_f32_bf16 v4, s29, v30
  v_dot2c_f32_bf16 v5, v30, v30
  v_dot2c_f32_bf16 v6, s29, v31
  v_dot2c_f32_bf16 v7, v31, v31
  s_waitcnt vmcnt(7)
  v_dot2c_f32_bf16 v4, s29, v32
  v_dot2c_f32_bf16 v5, v32, v32
  v_dot2c_f32_bf16 v6, s29, v33
  v_dot2c_f32_bf16 v7, v33, v33
  v_dot2c_f32_bf16 v4, s29, v34
  v_dot2c_f32_bf16 v5, v34, v34
  v_dot2c_f32_bf16 v6, s29, v35
  v_dot2c_f32_bf16 v7, v35, v35
  s_waitcnt vmcnt(6)
  v_dot2c_f32_bf16 v4, s29, v36
  v_dot2c_f32_bf16 v5, v36, v36
  v_dot2c_f32_bf16 v6, s29, v37
  v_dot2c_f32_bf16 v7, v37, v37
  v_dot2c_f32_bf16 v4, s29, v38
  v_dot2c_f32_bf16 v5, v38, v38
  v_dot2c_f32_bf16 v6, s29, v39
  v_dot2c_f32_bf16 v7, v39, v39
  s_waitcnt vmcnt(5)
  v_dot2c_f32_bf16 v4, s29, v40
  v_dot2c_f32_bf16 v5, v40, v40
  v_dot2c_f32_bf16 v6, s29, v41
  v_dot2c_f32_bf16 v7, v41, v41
  v_dot2c_f32_bf16 v4, s29, v42
  v_dot2c_f32_bf16 v5, v42, v42
  v_dot2c_f32_bf16 v6, s29, v43
  v_dot2c_f32_bf16 v7, v43, v43
  s_waitcnt vmcnt(4)
  v_dot2c_f32_bf16 v4, s29, v44
  v_dot2c_f32_bf16 v5, v44, v44
  v_dot2c_f32_bf16 v6, s29, v45
  v_dot2c_f32_bf16 v7, v45, v45
  v_dot2c_f32_bf16 v4, s29, v46
  v_dot2c_f32_bf16 v5, v46, v46
  v_dot2c_f32_bf16 v6, s29, v47
  v_dot2c_f32_bf16 v7, v47, v47
  s_cmp_lt_u32 s27, 6
  s_cbranch_scc1 L_ng7
  s_barrier
L_ng7:
  s_waitcnt vmcnt(3)
  v_dot2c_f32_bf16 v4, s29, v48
  v_dot2c_f32_bf16 v5, v48, v48
  v_dot2c_f32_bf16 v6, s29, v49
  v_dot2c_f32_bf16 v7, v49, v49
  v_dot2c_f32_bf16 v4, s29, v50
  v_dot2c_f32_bf16 v5, v50, v50
  v_dot2c_f32_bf16 v6, s29, v51
  v_dot2c_f32_bf16 v7, v51, v51
  s_waitcnt vmcnt(2)
  v_dot2c_f32_bf16 v4, s29, v52
  v_dot2c_f32_bf16 v5, v52, v52
  v_dot2c_f32_bf16 v6, s29, v53
  v_dot2c_f32_bf16 v7, v53, v53
  v_dot2c_f32_bf16 v4, s29, v54
  v_dot2c_f32_bf16 v5, v54, v54
  v_dot2c_f32_bf16 v6, s29, v55
  v_dot2c_f32_bf16 v7, v55, v55
  s_waitcnt vmcnt(1)
  v_dot2c_f32_bf16 v4, s29, v56
  v_dot2c_f32_bf16 v5, v56, v56
  v_dot2c_f32_bf16 v6, s29, v57
  v_dot2c_f32_bf16 v7, v57, v57
  v_dot2c_f32_bf16 v4, s29, v58
  v_dot2c_f32_bf16 v5, v58, v58
  v_dot2c_f32_bf16 v6, s29, v59
  v_dot2c_f32_bf16 v7, v59, v59
  s_waitcnt vmcnt(0)
  v_dot2c_f32_bf16 v4, s29, v60
  v_dot2c_f32_bf16 v5, v60, v60
  v_dot2c_f32_bf16 v6, s29, v61
  v_dot2c_f32_bf16 v7, v61, v61
  v_dot2c_f32_bf16 v4, s29, v62
  v_dot2c_f32_bf16 v5, v62, v62
  v_dot2c_f32_bf16 v6, s29, v63
  v_dot2c_f32_bf16 v7, v63, v63
  s_nop 1
  v_mov_b32 v66, 1
  v_add_f32 v4, v4, v6
  v_add_f32 v5, v5, v7
  s_nop 0
  v_add_f32_dpp v4, v4, v4 quad_perm:[1,0,3,2] row_mask:0xf bank_mask:0xf
  v_add_f32_dpp v5, v5, v5 quad_perm:[1,0,3,2] row_mask:0xf bank_mask:0xf
  s_nop 0
  v_add_f32_dpp v4, v4, v4 quad_perm:[2,3,0,1] row_mask:0xf bank_mask:0xf
  v_add_f32_dpp v5, v5, v5 quad_perm:[2,3,0,1] row_mask:0xf bank_mask:0xf
  s_nop 0
  v_add_f32_dpp v4, v4, v4 row_half_mirror row_mask:0xf bank_mask:0xf
  v_add_f32_dpp v5, v5, v5 row_half_mirror row_mask:0xf bank_mask:0xf
  s_nop 0
  v_add_f32_dpp v4, v4, v4 row_mirror row_mask:0xf bank_mask:0xf
  v_add_f32_dpp v5, v5, v5 row_mirror row_mask:0xf bank_mask:0xf
  s_nop 0
  v_add_f32_dpp v4, v4, v4 row_bcast:15 row_mask:0xa bank_mask:0xf
  v_add_f32_dpp v5, v5, v5 row_bcast:15 row_mask:0xa bank_mask:0xf
  s_nop 0
  v_add_f32_dpp v4, v4, v4 row_bcast:31 row_mask:0xc bank_mask:0xf
  v_add_f32_dpp v5, v5, v5 row_bcast:31 row_mask:0xc bank_mask:0xf
  s_mov_b32 exec_lo, 0
  s_mov_b32 exec_hi, 0x80000000
  ds_write_b64 v2, v[4:5]
  ds_add_rtn_u32 v6, v0, v66 offset:32
  s_mov_b64 exec, -1
  ds_read_b64 v[4:5], v65
  s_waitcnt lgkmcnt(0)
  v_readlane_b32 s15, v6, 63
  v_add_f32_dpp v4, v4, v4 quad_perm:[1,0,3,2] row_mask:0xf bank_mask:0xf
  v_add_f32_dpp v5, v5, v5 quad_perm:[1,0,3,2] row_mask:0xf bank_mask:0xf
  s_nop 0
  v_add_f32_dpp v4, v4, v4 quad_perm:[2,3,0,1] row_mask:0xf bank_mask:0xf
  v_add_f32_dpp v5, v5, v5 quad_perm:[2,3,0,1] row_mask:0xf bank_mask:0xf
  s_cmp_lg_u32 s15, 3
  s_cbranch_scc1 L_other
  s_cmp_lt_u32 s27, 4
  s_cbranch_scc1 L_cchk
L_cok:
  v_min_f32 v5, 0x7f800000, v5
  s_mov_b32 exec_hi, 0
  s_mov_b32 exec_lo, s13
  global_store_dwordx2 v64, v[4:5], s[10:11] sc1
  s_mov_b64 exec, -1
  s_cmp_lt_u32 s27, 4
  s_cbranch_scc0 L_r1
  s_cmp_eq_u32 s3, 0
  s_cbranch_scc1 L_ng1
  s_atomic_or s3, s[8:9], 192
L_ng1:
  s_barrier
  s_barrier
  s_load_dword s2, s[8:9], 192
  s_branch L_try
L_r1:
  s_barrier
L_try:
  s_cmp_ge_u32 s28, s14
  s_cselect_b32 s15, s26, s28
  s_cbranch_scc1 L_far
  s_add_u32 s28, s28, 128
  s_add_u32 s47, s15, 64
  s_load_dwordx16 s[64:79], s[10:11], s15
  s_load_dwordx16 s[80:95], s[10:11], s47
  s_branch L_ld
L_far:
  s_add_u32 s47, s15, 64
  s_load_dwordx16 s[64:79], s[10:11], s15 glc
  s_load_dwordx16 s[80:95], s[10:11], s47 glc
L_ld:
  s_add_u32 s31, s31, 1
  s_bitcmp1_b32 s31, 20
  s_waitcnt lgkmcnt(0)
  v_pk_add_f32 v[4:5], s[64:65], 0 op_sel_hi:[1,0]
  v_pk_add_f32 v[6:7], s[66:67], 0 op_sel_hi:[1,0]
  v_pk_add_f32 v[4:5], s[68:69], v[4:5]
  v_pk_add_f32 v[6:7], s[70:71], v[6:7]
  v_pk_add_f32 v[4:5], s[72:73], v[4:5]
  v_pk_add_f32 v[6:7], s[74:75], v[6:7]
  v_pk_add_f32 v[4:5], s[76:77], v[4:5]
  v_pk_add_f32 v[6:7], s[78:79], v[6:7]
  v_pk_add_f32 v[4:5], s[80:81], v[4:5]
  v_pk_add_f32 v[6:7], s[82:83], v[6:7]
  v_pk_add_f32 v[4:5], s[84:85], v[4:5]
  v_pk_add_f32 v[6:7], s[86:87], v[6:7]
  v_pk_add_f32 v[4:5], s[88:89], v[4:5]
  v_pk_add_f32 v[6:7], s[90:91], v[6:7]
  v_pk_add_f32 v[4:5], s[92:93], v[4:5]
  v_pk_add_f32 v[6:7], s[94:95], v[6:7]
  v_pk_add_f32 v[4:5], v[4:5], v[6:7]
  s_cbranch_scc1 L_got
  v_cmp_u_f32 vcc, v5, v5
  s_cbranch_vccnz L_try
L_got:
  v_mul_f32 v2, 0x36124925, v4
  v_mul_f32 v3, 0x36124925, v5
  v_fma_f32 v3, -v2, v2, v3
  v_cvt_pk_bf16_f32 v4, 0, v2
  v_sub_f32 v2, v2, v4
  v_fma_f32 v3, v2, v2, v3
  v_max_f32 v3, 0, v3
  v_cvt_pk_bf16_f32 v3, 0, v3
  v_add_f32 v3, 0x3727c5ac, v3
  v_cvt_pk_bf16_f32 v3, 0, v3
  v_sqrt_f32 v3, v3
  v_or_b32 v2, 1, v4
  v_cvt_pk_bf16_f32 v3, 0, v3
  v_rcp_f32 v3, v3
  s_mov_b64 exec, 1
  ds_write_b64 v0, v[2:3] offset:48
  s_mov_b64 exec, -1
  s_cmp_lt_u32 s27, 4
  s_cbranch_scc0 L_go
  s_cmp_lt_u32 s2, 0xff
  s_cbranch_scc1 L_gretry
L_g2:
  s_waitcnt lgkmcnt(0)
  s_barrier
  s_branch L_go
L_other:
  s_cmp_lt_u32 s27, 4
  s_cbranch_scc0 L_o1
  s_barrier
L_o1:
  s_cmp_lt_u32 s27, 6
  s_cbranch_scc0 L_ba
  s_barrier
L_ba:
  s_barrier
L_spin:
  ds_read_b64 v[2:3], v0 offset:48
  s_add_u32 s31, s31, 1
  s_bitcmp1_b32 s31, 24
  s_waitcnt lgkmcnt(0)
  s_cbranch_scc1 L_go
  v_cmp_eq_u32 vcc, 0, v2
  s_cbranch_vccnz L_spin
  s_branch L_go
L_cchk:
  s_load_dword s47, s[8:9], 128
  s_and_b32 s15, s2, 7
  s_lshl_b32 s15, 1, s15
  s_bfe_u32 s62, s2, 0x10006
  s_and_b32 s63, s2, 3
  s_lshl2_add_u32 s62, s62, s63
  s_bitset1_b32 s15, s62
  s_waitcnt lgkmcnt(0)
  s_andn2_b32 s47, s15, s47
  s_cbranch_scc1 L_cretry
L_c2:
  s_branch L_cok
L_go:
  v_and_b32 v2, s30, v2
  s_mov_b32 s47, s27
L_ch0:
  s_lshl_b32 s62, s32, 16
  s_lshl_b32 s63, s40, 16
  v_mul_f32 v64, s62, v3
  v_fma_f32 v65, -v2, v64, s63
  v_lshlrev_b32 v4, 16, v8
  v_and_b32 v5, s30, v8
  v_pk_fma_f32 v[4:5], v[4:5], v[64:65], v[64:65] op_sel:[0,0,1] op_sel_hi:[1,0,1]
  v_cvt_pk_bf16_f32 v8, v4, v5
  v_lshlrev_b32 v6, 16, v9
  v_and_b32 v7, s30, v9
  v_pk_fma_f32 v[6:7], v[6:7], v[64:65], v[64:65] op_sel:[0,0,1] op_sel_hi:[1,0,1]
  v_cvt_pk_bf16_f32 v9, v6, v7
  v_lshlrev_b32 v4, 16, v10
  v_and_b32 v5, s30, v10
  v_pk_fma_f32 v[4:5], v[4:5], v[64:65], v[64:65] op_sel:[0,0,1] op_sel_hi:[1,0,1]
  v_cvt_pk_bf16_f32 v10, v4, v5
  v_lshlrev_b32 v6, 16, v11
  v_and_b32 v7, s30, v11
  v_pk_fma_f32 v[6:7], v[6:7], v[64:65], v[64:65] op_sel:[0,0,1] op_sel_hi:[1,0,1]
  v_cvt_pk_bf16_f32 v11, v6, v7
  s_cbranch_execz L_ds0
  buffer_store_dwordx4 v[8:11], v1, s[20:23], s48 offen sc1
L_ds0:
  s_and_b32 s62, s32, s30
  s_and_b32 s63, s40, s30
  v_mul_f32 v64, s62, v3
  v_fma_f32 v65, -v2, v64, s63
  v_lshlrev_b32 v4, 16, v12
  v_and_b32 v5, s30, v12
  v_pk_fma_f32 v[4:5], v[4:5], v[64:65], v[64:65] op_sel:[0,0,1] op_sel_hi:[1,0,1]
  v_cvt_pk_bf16_f32 v12, v4, v5
  v_lshlrev_b32 v6, 16, v13
  v_and_b32 v7, s30, v13
  v_pk_fma_f32 v[6:7], v[6:7], v[64:65], v[64:65] op_sel:[0,0,1] op_sel_hi:[1,0,1]
  v_cvt_pk_bf16_f32 v13, v6, v7
  v_lshlrev_b32 v4, 16, v14
  v_and_b32 v5, s30, v14
  v_pk_fma_f32 v[4:5], v[4:5], v[64:65], v[64:65] op_sel:[0,0,1] op_sel_hi:[1,0,1]
  v_cvt_pk_bf16_f32 v14, v4, v5
  v_lshlrev_b32 v6, 16, v15
  v_and_b32 v7, s30, v15
  v_pk_fma_f32 v[6:7], v[6:7], v[64:65], v[64:65] op_sel:[0,0,1] op_sel_hi:[1,0,1]
  v_cvt_pk_bf16_f32 v15, v6, v7
  s_cbranch_execz L_ds1
  buffer_store_dwordx4 v[12:15], v1, s[20:23], s49 offen sc1
L_ds1:
  s_lshl_b32 s62, s33, 16
  s_lshl_b32 s63, s41, 16
  v_mul_f32 v64, s62, v3
  v_fma_f32 v65, -v2, v64, s63
  v_lshlrev_b32 v4, 16, v16
  v_and_b32 v5, s30, v16
  v_pk_fma_f32 v[4:5], v[4:5], v[64:65], v[64:65] op_sel:[0,0,1] op_sel_hi:[1,0,1]
  v_cvt_pk_bf16_f32 v16, v4, v5
  v_lshlrev_b32 v6, 16, v17
  v_and_b32 v7, s30, v17
  v_pk_fma_f32 v[6:7], v[6:7], v[64:65], v[64:65] op_sel:[0,0,1] op_sel_hi:[1,0,1]
  v_cvt_pk_bf16_f32 v17, v6, v7
  v_lshlrev_b32 v4, 16, v18
  v_and_b32 v5, s30, v18
  v_pk_fma_f32 v[4:5], v[4:5], v[64:65], v[64:65] op_sel:[0,0,1] op_sel_hi:[1,0,1]
  v_cvt_pk_bf16_f32 v18, v4, v5
  v_lshlrev_b32 v6, 16, v19
  v_and_b32 v7, s30, v19
  v_pk_fma_f32 v[6:7], v[6:7], v[64:65], v[64:65] op_sel:[0,0,1] op_sel_hi:[1,0,1]
  v_cvt_pk_bf16_f32 v19, v6, v7
  s_cbranch_execz L_ds2
  buffer_store_dwordx4 v[16:19], v1, s[20:23], s50 offen sc1
L_ds2:
  s_and_b32 s62, s33, s30
  s_and_b32 s63, s41, s30
  v_mul_f32 v64, s62, v3
  v_fma_f32 v65, -v2, v64, s63
  v_lshlrev_b32 v4, 16, v20
  v_and_b32 v5, s30, v20
  v_pk_fma_f32 v[4:5], v[4:5], v[64:65], v[64:65] op_sel:[0,0,1] op_sel_hi:[1,0,1]
  v_cvt_pk_bf16_f32 v20, v4, v5
  v_lshlrev_b32 v6, 16, v21
  v_and_b32 v7, s30, v21
  v_pk_fma_f32 v[6:7], v[6:7], v[64:65], v[64:65] op_sel:[0,0,1] op_sel_hi:[1,0,1]
  v_cvt_pk_bf16_f32 v21, v6, v7
  v_lshlrev_b32 v4, 16, v22
  v_and_b32 v5, s30, v22
  v_pk_fma_f32 v[4:5], v[4:5], v[64:65], v[64:65] op_sel:[0,0,1] op_sel_hi:[1,0,1]
  v_cvt_pk_bf16_f32 v22, v4, v5
  v_lshlrev_b32 v6, 16, v23
  v_and_b32 v7, s30, v23
  v_pk_fma_f32 v[6:7], v[6:7], v[64:65], v[64:65] op_sel:[0,0,1] op_sel_hi:[1,0,1]
  v_cvt_pk_bf16_f32 v23, v6, v7
  s_cbranch_execz L_ds3
  buffer_store_dwordx4 v[20:23], v1, s[20:23], s51 offen sc1
L_ds3:
  s_lshl_b32 s62, s34, 16
  s_lshl_b32 s63, s42, 16
  v_mul_f32 v64, s62, v3
  v_fma_f32 v65, -v2, v64, s63
  v_lshlrev_b32 v4, 16, v24
  v_and_b32 v5, s30, v24
  v_pk_fma_f32 v[4:5], v[4:5], v[64:65], v[64:65] op_sel:[0,0,1] op_sel_hi:[1,0,1]
  v_cvt_pk_bf16_f32 v24, v4, v5
  v_lshlrev_b32 v6, 16, v25
  v_and_b32 v7, s30, v25
  v_pk_fma_f32 v[6:7], v[6:7], v[64:65], v[64:65] op_sel:[0,0,1] op_sel_hi:[1,0,1]
  v_cvt_pk_bf16_f32 v25, v6, v7
  v_lshlrev_b32 v4, 16, v26
  v_and_b32 v5, s30, v26
  v_pk_fma_f32 v[4:5], v[4:5], v[64:65], v[64:65] op_sel:[0,0,1] op_sel_hi:[1,0,1]
  v_cvt_pk_bf16_f32 v26, v4, v5
  v_lshlrev_b32 v6, 16, v27
  v_and_b32 v7, s30, v27
  v_pk_fma_f32 v[6:7], v[6:7], v[64:65], v[64:65] op_sel:[0,0,1] op_sel_hi:[1,0,1]
  v_cvt_pk_bf16_f32 v27, v6, v7
  s_cmp_lt_u32 s47, 4
  s_cbranch_scc0 L_sw4
  s_waitcnt vmcnt(3)
L_sw4:
  s_cbranch_execz L_ds4
  buffer_store_dwordx4 v[24:27], v1, s[20:23], s52 offen sc1
L_ds4:
  s_and_b32 s62, s34, s30
  s_and_b32 s63, s42, s30
  v_mul_f32 v64, s62, v3
  v_fma_f32 v65, -v2, v64, s63
  v_lshlrev_b32 v4, 16, v28
  v_and_b32 v5, s30, v28
  v_pk_fma_f32 v[4:5], v[4:5], v[64:65], v[64:65] op_sel:[0,0,1] op_sel_hi:[1,0,1]
  v_cvt_pk_bf16_f32 v28, v4, v5
  v_lshlrev_b32 v6, 16, v29
  v_and_b32 v7, s30, v29
  v_pk_fma_f32 v[6:7], v[6:7], v[64:65], v[64:65] op_sel:[0,0,1] op_sel_hi:[1,0,1]
  v_cvt_pk_bf16_f32 v29, v6, v7
  v_lshlrev_b32 v4, 16, v30
  v_and_b32 v5, s30, v30
  v_pk_fma_f32 v[4:5], v[4:5], v[64:65], v[64:65] op_sel:[0,0,1] op_sel_hi:[1,0,1]
  v_cvt_pk_bf16_f32 v30, v4, v5
  v_lshlrev_b32 v6, 16, v31
  v_and_b32 v7, s30, v31
  v_pk_fma_f32 v[6:7], v[6:7], v[64:65], v[64:65] op_sel:[0,0,1] op_sel_hi:[1,0,1]
  v_cvt_pk_bf16_f32 v31, v6, v7
  s_cmp_lt_u32 s47, 4
  s_cbranch_scc0 L_sw5
  s_waitcnt vmcnt(3)
L_sw5:
  s_cbranch_execz L_ds5
  buffer_store_dwordx4 v[28:31], v1, s[20:23], s53 offen sc1
L_ds5:
  s_lshl_b32 s62, s35, 16
  s_lshl_b32 s63, s43, 16
  v_mul_f32 v64, s62, v3
  v_fma_f32 v65, -v2, v64, s63
  v_lshlrev_b32 v4, 16, v32
  v_and_b32 v5, s30, v32
  v_pk_fma_f32 v[4:5], v[4:5], v[64:65], v[64:65] op_sel:[0,0,1] op_sel_hi:[1,0,1]
  v_cvt_pk_bf16_f32 v32, v4, v5
  v_lshlrev_b32 v6, 16, v33
  v_and_b32 v7, s30, v33
  v_pk_fma_f32 v[6:7], v[6:7], v[64:65], v[64:65] op_sel:[0,0,1] op_sel_hi:[1,0,1]
  v_cvt_pk_bf16_f32 v33, v6, v7
  v_lshlrev_b32 v4, 16, v34
  v_and_b32 v5, s30, v34
  v_pk_fma_f32 v[4:5], v[4:5], v[64:65], v[64:65] op_sel:[0,0,1] op_sel_hi:[1,0,1]
  v_cvt_pk_bf16_f32 v34, v4, v5
  v_lshlrev_b32 v6, 16, v35
  v_and_b32 v7, s30, v35
  v_pk_fma_f32 v[6:7], v[6:7], v[64:65], v[64:65] op_sel:[0,0,1] op_sel_hi:[1,0,1]
  v_cvt_pk_bf16_f32 v35, v6, v7
  s_cmp_lt_u32 s47, 4
  s_cbranch_scc0 L_sw6
  s_waitcnt vmcnt(3)
L_sw6:
  s_cbranch_execz L_back
  buffer_store_dwordx4 v[32:35], v1, s[20:23], s54 offen sc1
L_ds6:
L_ch7:
  s_and_b32 s62, s35, s30
  s_and_b32 s63, s43, s30
  v_mul_f32 v64, s62, v3
  v_fma_f32 v65, -v2, v64, s63
  v_lshlrev_b32 v4, 16, v36
  v_and_b32 v5, s30, v36
  v_pk_fma_f32 v[4:5], v[4:5], v[64:65], v[64:65] op_sel:[0,0,1] op_sel_hi:[1,0,1]
  v_cvt_pk_bf16_f32 v36, v4, v5
  v_lshlrev_b32 v6, 16, v37
  v_and_b32 v7, s30, v37
  v_pk_fma_f32 v[6:7], v[6:7], v[64:65], v[64:65] op_sel:[0,0,1] op_sel_hi:[1,0,1]
  v_cvt_pk_bf16_f32 v37, v6, v7
  v_lshlrev_b32 v4, 16, v38
  v_and_b32 v5, s30, v38
  v_pk_fma_f32 v[4:5], v[4:5], v[64:65], v[64:65] op_sel:[0,0,1] op_sel_hi:[1,0,1]
  v_cvt_pk_bf16_f32 v38, v4, v5
  v_lshlrev_b32 v6, 16, v39
  v_and_b32 v7, s30, v39
  v_pk_fma_f32 v[6:7], v[6:7], v[64:65], v[64:65] op_sel:[0,0,1] op_sel_hi:[1,0,1]
  v_cvt_pk_bf16_f32 v39, v6, v7
  s_cmp_lt_u32 s47, 4
  s_cbranch_scc0 L_sw7
  s_waitcnt vmcnt(3)
L_sw7:
  s_cbranch_execz L_ds7
  buffer_store_dwordx4 v[36:39], v1, s[20:23], s55 offen sc1
L_ds7:
  s_lshl_b32 s62, s36, 16
  s_lshl_b32 s63, s44, 16
  v_mul_f32 v64, s62, v3
  v_fma_f32 v65, -v2, v64, s63
  v_lshlrev_b32 v4, 16, v40
  v_and_b32 v5, s30, v40
  v_pk_fma_f32 v[4:5], v[4:5], v[64:65], v[64:65] op_sel:[0,0,1] op_sel_hi:[1,0,1]
  v_cvt_pk_bf16_f32 v40, v4, v5
  v_lshlrev_b32 v6, 16, v41
  v_and_b32 v7, s30, v41
  v_pk_fma_f32 v[6:7], v[6:7], v[64:65], v[64:65] op_sel:[0,0,1] op_sel_hi:[1,0,1]
  v_cvt_pk_bf16_f32 v41, v6, v7
  v_lshlrev_b32 v4, 16, v42
  v_and_b32 v5, s30, v42
  v_pk_fma_f32 v[4:5], v[4:5], v[64:65], v[64:65] op_sel:[0,0,1] op_sel_hi:[1,0,1]
  v_cvt_pk_bf16_f32 v42, v4, v5
  v_lshlrev_b32 v6, 16, v43
  v_and_b32 v7, s30, v43
  v_pk_fma_f32 v[6:7], v[6:7], v[64:65], v[64:65] op_sel:[0,0,1] op_sel_hi:[1,0,1]
  v_cvt_pk_bf16_f32 v43, v6, v7
  s_cmp_lt_u32 s47, 4
  s_cbranch_scc0 L_sw8
  s_waitcnt vmcnt(3)
L_sw8:
  s_cbranch_execz L_ds8
  buffer_store_dwordx4 v[40:43], v1, s[20:23], s56 offen sc1
L_ds8:
  s_and_b32 s62, s36, s30
  s_and_b32 s63, s44, s30
  v_mul_f32 v64, s62, v3
  v_fma_f32 v65, -v2, v64, s63
  v_lshlrev_b32 v4, 16, v44
  v_and_b32 v5, s30, v44
  v_pk_fma_f32 v[4:5], v[4:5], v[64:65], v[64:65] op_sel:[0,0,1] op_sel_hi:[1,0,1]
  v_cvt_pk_bf16_f32 v44, v4, v5
  v_lshlrev_b32 v6, 16, v45
  v_and_b32 v7, s30, v45
  v_pk_fma_f32 v[6:7], v[6:7], v[64:65], v[64:65] op_sel:[0,0,1] op_sel_hi:[1,0,1]
  v_cvt_pk_bf16_f32 v45, v6, v7
  v_lshlrev_b32 v4, 16, v46
  v_and_b32 v5, s30, v46
  v_pk_fma_f32 v[4:5], v[4:5], v[64:65], v[64:65] op_sel:[0,0,1] op_sel_hi:[1,0,1]
  v_cvt_pk_bf16_f32 v46, v4, v5
  v_lshlrev_b32 v6, 16, v47
  v_and_b32 v7, s30, v47
  v_pk_fma_f32 v[6:7], v[6:7], v[64:65], v[64:65] op_sel:[0,0,1] op_sel_hi:[1,0,1]
  v_cvt_pk_bf16_f32 v47, v6, v7
  s_cmp_lt_u32 s47, 4
  s_cbranch_scc0 L_sw9
  s_waitcnt vmcnt(3)
L_sw9:
  s_cbranch_execz L_ds9
  buffer_store_dwordx4 v[44:47], v1, s[20:23], s57 offen sc1
L_ds9:
  s_lshl_b32 s62, s37, 16
  s_lshl_b32 s63, s45, 16
  v_mul_f32 v64, s62, v3
  v_fma_f32 v65, -v2, v64, s63
  v_lshlrev_b32 v4, 16, v48
  v_and_b32 v5, s30, v48
  v_pk_fma_f32 v[4:5], v[4:5], v[64:65], v[64:65] op_sel:[0,0,1] op_sel_hi:[1,0,1]
  v_cvt_pk_bf16_f32 v48, v4, v5
  v_lshlrev_b32 v6, 16, v49
  v_and_b32 v7, s30, v49
  v_pk_fma_f32 v[6:7], v[6:7], v[64:65], v[64:65] op_sel:[0,0,1] op_sel_hi:[1,0,1]
  v_cvt_pk_bf16_f32 v49, v6, v7
  v_lshlrev_b32 v4, 16, v50
  v_and_b32 v5, s30, v50
  v_pk_fma_f32 v[4:5], v[4:5], v[64:65], v[64:65] op_sel:[0,0,1] op_sel_hi:[1,0,1]
  v_cvt_pk_bf16_f32 v50, v4, v5
  v_lshlrev_b32 v6, 16, v51
  v_and_b32 v7, s30, v51
  v_pk_fma_f32 v[6:7], v[6:7], v[64:65], v[64:65] op_sel:[0,0,1] op_sel_hi:[1,0,1]
  v_cvt_pk_bf16_f32 v51, v6, v7
  s_cmp_lt_u32 s47, 4
  s_cbranch_scc0 L_sw10
  s_waitcnt vmcnt(3)
L_sw10:
  s_cbranch_execz L_ds10
  buffer_store_dwordx4 v[48:51], v1, s[20:23], s58 offen sc1
L_ds10:
  s_and_b32 s62, s37, s30
  s_and_b32 s63, s45, s30
  v_mul_f32 v64, s62, v3
  v_fma_f32 v65, -v2, v64, s63
  v_lshlrev_b32 v4, 16, v52
  v_and_b32 v5, s30, v52
  v_pk_fma_f32 v[4:5], v[4:5], v[64:65], v[64:65] op_sel:[0,0,1] op_sel_hi:[1,0,1]
  v_cvt_pk_bf16_f32 v52, v4, v5
  v_lshlrev_b32 v6, 16, v53
  v_and_b32 v7, s30, v53
  v_pk_fma_f32 v[6:7], v[6:7], v[64:65], v[64:65] op_sel:[0,0,1] op_sel_hi:[1,0,1]
  v_cvt_pk_bf16_f32 v53, v6, v7
  v_lshlrev_b32 v4, 16, v54
  v_and_b32 v5, s30, v54
  v_pk_fma_f32 v[4:5], v[4:5], v[64:65], v[64:65] op_sel:[0,0,1] op_sel_hi:[1,0,1]
  v_cvt_pk_bf16_f32 v54, v4, v5
  v_lshlrev_b32 v6, 16, v55
  v_and_b32 v7, s30, v55
  v_pk_fma_f32 v[6:7], v[6:7], v[64:65], v[64:65] op_sel:[0,0,1] op_sel_hi:[1,0,1]
  v_cvt_pk_bf16_f32 v55, v6, v7
  s_cmp_lt_u32 s47, 4
  s_cbranch_scc0 L_sw11
  s_waitcnt vmcnt(3)
L_sw11:
  s_cbranch_execz L_ds11
  buffer_store_dwordx4 v[52:55], v1, s[20:23], s59 offen sc1
L_ds11:
  s_lshl_b32 s62, s38, 16
  s_lshl_b32 s63, s46, 16
  v_mul_f32 v64, s62, v3
  v_fma_f32 v65, -v2, v64, s63
  v_lshlrev_b32 v4, 16, v56
  v_and_b32 v5, s30, v56
  v_pk_fma_f32 v[4:5], v[4:5], v[64:65], v[64:65] op_sel:[0,0,1] op_sel_hi:[1,0,1]
  v_cvt_pk_bf16_f32 v56, v4, v5
  v_lshlrev_b32 v6, 16, v57
  v_and_b32 v7, s30, v57
  v_pk_fma_f32 v[6:7], v[6:7], v[64:65], v[64:65] op_sel:[0,0,1] op_sel_hi:[1,0,1]
  v_cvt_pk_bf16_f32 v57, v6, v7
  v_lshlrev_b32 v4, 16, v58
  v_and_b32 v5, s30, v58
  v_pk_fma_f32 v[4:5], v[4:5], v[64:65], v[64:65] op_sel:[0,0,1] op_sel_hi:[1,0,1]
  v_cvt_pk_bf16_f32 v58, v4, v5
  v_lshlrev_b32 v6, 16, v59
  v_and_b32 v7, s30, v59
  v_pk_fma_f32 v[6:7], v[6:7], v[64:65], v[64:65] op_sel:[0,0,1] op_sel_hi:[1,0,1]
  v_cvt_pk_bf16_f32 v59, v6, v7
  s_cmp_lt_u32 s47, 4
  s_cbranch_scc0 L_sw12
  s_waitcnt vmcnt(3)
L_sw12:
  s_cbranch_execz L_ds12
  buffer_store_dwordx4 v[56:59], v1, s[20:23], s60 offen sc1
L_ds12:
  s_and_b32 s62, s38, s30
  s_and_b32 s63, s46, s30
  v_mul_f32 v64, s62, v3
  v_fma_f32 v65, -v2, v64, s63
  v_lshlrev_b32 v4, 16, v60
  v_and_b32 v5, s30, v60
  v_pk_fma_f32 v[4:5], v[4:5], v[64:65], v[64:65] op_sel:[0,0,1] op_sel_hi:[1,0,1]
  v_cvt_pk_bf16_f32 v60, v4, v5
  v_lshlrev_b32 v6, 16, v61
  v_and_b32 v7, s30, v61
  v_pk_fma_f32 v[6:7], v[6:7], v[64:65], v[64:65] op_sel:[0,0,1] op_sel_hi:[1,0,1]
  v_cvt_pk_bf16_f32 v61, v6, v7
  v_lshlrev_b32 v4, 16, v62
  v_and_b32 v5, s30, v62
  v_pk_fma_f32 v[4:5], v[4:5], v[64:65], v[64:65] op_sel:[0,0,1] op_sel_hi:[1,0,1]
  v_cvt_pk_bf16_f32 v62, v4, v5
  v_lshlrev_b32 v6, 16, v63
  v_and_b32 v7, s30, v63
  v_pk_fma_f32 v[6:7], v[6:7], v[64:65], v[64:65] op_sel:[0,0,1] op_sel_hi:[1,0,1]
  v_cvt_pk_bf16_f32 v63, v6, v7
  s_cmp_lt_u32 s47, 4
  s_cbranch_scc0 L_sw13
  s_waitcnt vmcnt(3)
L_sw13:
  s_cbranch_execz L_back
  buffer_store_dwordx4 v[60:63], v1, s[20:23], s61 offen sc1
L_ds13:
L_end:
  s_endpgm
.section .rodata,"a"
.p2align 6
.p2align 6
.amdhsa_kernel standalone__groupnorm__prompt_kernel
  .amdhsa_next_free_vgpr 68
  .amdhsa_next_free_sgpr 96
  .amdhsa_accum_offset 68
  .amdhsa_group_segment_fixed_size 0
  .amdhsa_kernarg_size 48
  .amdhsa_user_sgpr_count 2
  .amdhsa_user_sgpr_kernarg_segment_ptr 1
  .amdhsa_system_sgpr_workgroup_id_x 1
  .amdhsa_float_denorm_mode_32 3
.end_amdhsa_kernel
```
